```python
import torch

def _softmax(x, axis=-1):
    return torch.softmax(x, dim=axis)
def _gelu(x):
    return torch.nn.functional.gelu(x, approximate="tanh")
def _silu(x):
    return torch.nn.functional.silu(x)
def _sigmoid(x):
    return torch.sigmoid(x)
def _layernorm(x, axis=-1, eps=1e-5):
    m = x.mean(dim=axis, keepdim=True)
    v = x.var(dim=axis, keepdim=True, unbiased=False)
    return (x - m) / torch.sqrt(v + eps)
def _scatter_add(tgt, idx, src, axis=0):
    return tgt.clone().index_add_(axis, idx, src)
def _segment_sum(src, seg, n):
    out = torch.zeros((n,) + src.shape[1:], dtype=src.dtype)
    return out.index_add_(0, seg, src)
def _pad(x, pw):
    flat = tuple(v for pair in reversed(pw) for v in pair)
    return torch.nn.functional.pad(x, flat)

kernel_name = 'standalone__kv_cache_quant_int4_int2_kv_with_per_channel_or_per_token_scales__decode'

def setup_inputs():

    _w = (lambda a: (lambda t: t.to(torch.bfloat16) if t.is_floating_point() else t)(torch.as_tensor(a)))
    B = 8
    Sq = 1
    Skv = 4096
    Hq = 16
    Hkv = 8
    Dh = 256
    bits = 3
    G = 128
    if G <= 0 or G >= Skv:
        G = max(1, Skv // 2)
    Skv = (Skv // G) * G
    ngk = Skv // G
    qmax = (1 << bits) - 1
    return {
        "q": _w((lambda *s: torch.randn(*s, dtype=torch.bfloat16) * 3.2)(B, Hq, Sq, Dh)),
        "qk": _w(torch.randint(0, qmax + 1, (B, Hkv, Skv, Dh)).to(torch.int32)),
        "qv": _w(torch.randint(0, qmax + 1, (B, Hkv, Skv, Dh)).to(torch.int32)),
        "k_scales": _w(torch.abs((lambda *s: torch.randn(*s, dtype=torch.bfloat16) * 3.2)(B, Hkv, ngk, Dh)) * 0.05 + 0.02),
        "k_zeros": _w((lambda *s: torch.randn(*s, dtype=torch.bfloat16) * 3.2)(B, Hkv, ngk, Dh) + float(qmax) / 2.0),
        "v_scales": _w(torch.abs((lambda *s: torch.randn(*s, dtype=torch.bfloat16) * 0.05)(B, Hkv, Skv, 1)) * 0.05 + 0.02),
        "v_zeros": _w((lambda *s: torch.randn(*s, dtype=torch.bfloat16) * 0.05)(B, Hkv, Skv, 1) + float(qmax) / 2.0),
    }

def reference(q, qk, qv, k_scales, k_zeros, v_scales, v_zeros):
    B, Hq, Sq, Dh = q.shape
    Hkv, Skv = qk.shape[1], qk.shape[2]
    ngk = k_scales.shape[2]
    G = Skv // ngk
    ks = (lambda x, n, axis: torch.repeat_interleave(x, n, dim=axis))(k_scales, G, axis=2)
    kz = (lambda x, n, axis: torch.repeat_interleave(x, n, dim=axis))(k_zeros, G, axis=2)
    k = ((lambda x, dt: x.to(dt))(qk, q.dtype) - kz) * ks
    v = ((lambda x, dt: x.to(dt))(qv, q.dtype) - v_zeros) * v_scales
    rep = Hq // Hkv
    if rep > 1:
        k = (lambda x, n, axis: torch.repeat_interleave(x, n, dim=axis))(k, rep, axis=1)
        v = (lambda x, n, axis: torch.repeat_interleave(x, n, dim=axis))(v, rep, axis=1)
    scale = float(Dh) ** -0.5
    logits = torch.einsum("bhqd,bhkd->bhqk", q, k) * scale
    p = _softmax(logits, axis=-1)
    o = torch.einsum("bhqk,bhkd->bhqd", p, v)
    return o
```

```asm
; @launch grid=(256,1,1) block=(320,1,1) lds=90000
.amdgcn_target "amdgcn-amd-amdhsa--gfx950"
.text
.globl standalone__kv_cache_quant_int4_int2_kv_with_per_channel_or_per_token_scales__decode_kernel
.p2align 8
.type standalone__kv_cache_quant_int4_int2_kv_with_per_channel_or_per_token_scales__decode_kernel,@function
standalone__kv_cache_quant_int4_int2_kv_with_per_channel_or_per_token_scales__decode_kernel:
    s_cmp_ge_u32 s2, 256
    s_cbranch_scc1 L_end
    s_load_dwordx16 s[4:19], s[0:1], 0
    s_load_dwordx4 s[20:23], s[0:1], 64
    v_lshrrev_b32 v1, 6, v0
    s_nop 0
    v_readfirstlane_b32 s33, v1
    v_and_b32 v1, 63, v0
    v_lshlrev_b32 v3, 4, v1
    v_lshlrev_b32 v4, 3, v1
    s_mul_i32 s38, s33, 1024
    v_add_u32 v2, s38, v3
    v_and_b32 v44, 3, v1
    v_lshlrev_b32 v44, 4, v44
    v_bfe_u32 v45, v1, 4, 1
    v_lshl_add_u32 v44, v45, 1, v44
    v_bfe_u32 v45, v1, 3, 1
    v_lshl_add_u32 v44, v45, 2, v44
    v_bfe_u32 v45, v1, 2, 1
    v_lshl_add_u32 v44, v45, 3, v44
    v_lshrrev_b32 v45, 0, v44
    v_lshlrev_b32 v45, 3, v45
    v_and_b32 v44, 0, v44
    v_lshl_add_u32 v44, v44, 1, v45
    s_mul_i32 s38, s33, 2
    v_add_u32 v5, s38, v44
    s_lshr_b32 s28, s2, 2
    s_and_b32 s38, s2, 3
    s_mov_b32 s100, s38
    s_cmp_ge_u32 s38, 36
    s_cselect_b32 s3, 1, 0
    s_and_b32 s35, s38, 3
    s_lshr_b32 s38, s38, 2
    s_lshl_b32 s94, s38, 3
    s_mov_b32 s93, 4
    s_lshl_b32 s39, s38, 2
    s_add_u32 s39, s39, 8
    s_cmp_ge_u32 s38, 2
    s_cselect_b32 s94, s39, s94
    s_cselect_b32 s93, 2, s93
    s_lshl_b32 s39, s38, 1
    s_add_u32 s39, s39, 14
    s_cmp_ge_u32 s38, 3
    s_cselect_b32 s94, s39, s94
    s_cselect_b32 s93, 1, s93
    s_add_u32 s39, s38, 23
    s_cmp_ge_u32 s38, 9
    s_cselect_b32 s94, s39, s94
    s_cselect_b32 s39, 1, 0
    s_mul_i32 s35, s35, 32
    s_add_u32 s94, s94, s35
    s_cmp_eq_u32 s3, 1
    s_cselect_b32 s93, 0, s93
    s_cselect_b32 s94, 0, s94
    s_lshl_b32 s35, s28, 7
    s_add_u32 s94, s35, s94
    s_lshl_b32 s35, s94, 15
    s_add_u32 s88, s35, 0x8000
    s_cmp_eq_u32 s39, 1
    s_cselect_b32 s88, s88, 0x10000000
    s_mov_b32 s89, 0x11111111
    s_cselect_b32 s89, 0x01010101, s89
    s_cmp_eq_u32 s93, 0
    s_cselect_b32 s88, 0, s88
    s_lshl_b32 s38, s28, 10
    v_add_u32 v45, s38, v4
    s_mov_b32 s92, 0x3db8aa3b
    s_mov_b32 s29, 0
    s_lshl_b32 s38, s28, 2
    v_mov_b32 v49, s38
    v_mov_b32 v50, 1
    v_mov_b32 v53, 0xff800000
    v_mov_b32 v54, 0
    v_mov_b32 v36, 0
    v_mov_b32 v37, 0
    v_mov_b32 v38, 0
    v_mov_b32 v39, 0
    v_mov_b32 v40, 0
    v_mov_b32 v41, 0
    v_mov_b32 v42, 0
    v_mov_b32 v43, 0
    s_waitcnt lgkmcnt(0)
    s_cmp_eq_u32 s33, 4
    s_cbranch_scc1 L_helper
    s_and_b32 s7, s7, 0xffff
    s_and_b32 s9, s9, 0xffff
    s_mov_b32 s24, s6
    s_mov_b32 s25, s7
    s_mov_b32 s26, 0x10000000
    s_mov_b32 s27, 0x00020000
    s_mov_b32 s96, s6
    s_mov_b32 s97, s7
    s_mov_b32 s98, 0x10000000
    s_mov_b32 s99, 0x00020000
    global_load_dwordx2 v[14:15], v45, s[4:5]
    global_load_dwordx2 v[16:17], v45, s[4:5] offset:512
    s_lshr_b32 s38, s94, 2
    s_lshl_b32 s38, s38, 9
    v_add_u32 v68, s38, v4
    s_cmp_eq_u32 s93, 4
    s_cselect_b32 s38, 0x200, 0
    v_add_u32 v69, s38, v68
    global_load_dwordx2 v[60:61], v68, s[12:13]
    global_load_dwordx2 v[62:63], v69, s[12:13]
    global_load_dwordx2 v[64:65], v68, s[10:11]
    global_load_dwordx2 v[66:67], v69, s[10:11]
    s_lshl_b32 s38, s94, 6
    v_add_u32 v68, s38, v5
    v_min_u32 v68, 0x7fff6, v68
    global_load_ushort v57, v68, s[16:17]
    global_load_ushort v58, v68, s[14:15]
    global_load_ushort v59, v68, s[16:17] offset:8
    global_load_ushort v70, v68, s[14:15] offset:8
    s_mov_b32 s31, s35
    buffer_load_dwordx4 v[72:75], v2, s[24:27], s31 offen nt
    s_add_u32 s3, s31, 0x1000
    buffer_load_dwordx4 v[76:79], v2, s[24:27], s3 offen nt
    s_add_u32 s3, s31, 0x2000
    buffer_load_dwordx4 v[80:83], v2, s[24:27], s3 offen nt
    s_add_u32 s3, s31, 0x3000
    buffer_load_dwordx4 v[84:87], v2, s[24:27], s3 offen nt
    s_add_u32 s3, s31, 0x4000
    buffer_load_dwordx4 v[88:91], v2, s[24:27], s3 offen nt
    s_add_u32 s3, s31, 0x5000
    buffer_load_dwordx4 v[92:95], v2, s[24:27], s3 offen nt
    s_add_u32 s3, s31, 0x6000
    buffer_load_dwordx4 v[96:99], v2, s[24:27], s3 offen nt
    s_add_u32 s3, s31, 0x7000
    buffer_load_dwordx4 v[100:103], v2, s[24:27], s3 offen nt
    s_add_u32 s3, s31, 0x8000
    buffer_load_dwordx4 v[104:107], v2, s[24:27], s3 offen nt
    s_add_u32 s3, s31, 0x9000
    buffer_load_dwordx4 v[108:111], v2, s[24:27], s3 offen nt
    s_add_u32 s3, s31, 0xa000
    buffer_load_dwordx4 v[112:115], v2, s[24:27], s3 offen nt
    s_add_u32 s3, s31, 0xb000
    buffer_load_dwordx4 v[116:119], v2, s[24:27], s3 offen nt
    s_add_u32 s3, s31, 0xc000
    buffer_load_dwordx4 v[120:123], v2, s[24:27], s3 offen nt
    s_add_u32 s3, s31, 0xd000
    buffer_load_dwordx4 v[124:127], v2, s[24:27], s3 offen nt
    s_add_u32 s3, s31, 0xe000
    buffer_load_dwordx4 v[128:131], v2, s[24:27], s3 offen nt
    s_add_u32 s3, s31, 0xf000
    buffer_load_dwordx4 v[132:135], v2, s[24:27], s3 offen nt
L_task:
    s_barrier
    s_mov_b32 s30, s35
    s_mov_b32 s34, s93
    s_mov_b32 s90, s88
    s_waitcnt vmcnt(16)
    v_lshlrev_b32 v6, 16, v60
    v_and_b32 v7, 0xffff0000, v60
    v_lshlrev_b32 v8, 16, v61
    v_and_b32 v9, 0xffff0000, v61
    v_lshlrev_b32 v10, 16, v64
    v_and_b32 v11, 0xffff0000, v64
    v_lshlrev_b32 v12, 16, v65
    v_and_b32 v13, 0xffff0000, v65
    v_lshl_or_b32 v55, v58, 16, v57
    v_lshl_or_b32 v56, v70, 16, v59
    v_mov_b32 v34, 0xff800000
    v_mov_b32 v35, 0xff800000
    s_mov_b32 s32, 0
    s_mov_b32 s36, s89
    s_mov_b32 s37, s89
    s_nop 1
L_kloop:
    s_lshl_b32 s31, s32, 16
    s_add_u32 s31, s31, s30
    s_mov_b32 s24, s6
    s_mov_b32 s25, s7
    s_mov_b32 s26, s90
    s_add_u32 s95, s31, 0x10000
    s_add_u32 s32, s32, 1
    s_cmp_lt_u32 s32, s34
    s_cselect_b32 s96, s6, s8
    s_cselect_b32 s97, s7, s9
    s_cselect_b32 s95, s95, s30
    s_mov_b32 s98, s90
    s_waitcnt vmcnt(14)
    v_cvt_f32_i32 v72, v72
    v_cvt_f32_i32 v73, v73
    v_cvt_f32_i32 v74, v74
    v_cvt_f32_i32 v75, v75
    v_cvt_f32_i32 v76, v76
    v_cvt_f32_i32 v77, v77
    v_cvt_f32_i32 v78, v78
    v_cvt_f32_i32 v79, v79
    v_sub_f32 v72, v72, v6
    v_sub_f32 v73, v73, v7
    v_sub_f32 v74, v74, v8
    v_sub_f32 v75, v75, v9
    v_sub_f32 v76, v76, v6
    v_sub_f32 v77, v77, v7
    v_sub_f32 v78, v78, v8
    v_sub_f32 v79, v79, v9
    v_cvt_pk_bf16_f32 v72, 0, v72
    v_cvt_pk_bf16_f32 v73, 0, v73
    v_cvt_pk_bf16_f32 v74, 0, v74
    v_cvt_pk_bf16_f32 v75, 0, v75
    v_cvt_pk_bf16_f32 v76, 0, v76
    v_cvt_pk_bf16_f32 v77, 0, v77
    v_cvt_pk_bf16_f32 v78, 0, v78
    v_cvt_pk_bf16_f32 v79, 0, v79
    v_mul_f32 v72, v72, v10
    v_mul_f32 v73, v73, v11
    v_mul_f32 v74, v74, v12
    v_mul_f32 v75, v75, v13
    v_mul_f32 v76, v76, v10
    v_mul_f32 v77, v77, v11
    v_mul_f32 v78, v78, v12
    v_mul_f32 v79, v79, v13
    v_cvt_pk_bf16_f32 v18, v72, v73
    v_cvt_pk_bf16_f32 v19, v74, v75
    v_cvt_pk_bf16_f32 v20, v76, v77
    v_cvt_pk_bf16_f32 v21, v78, v79
    buffer_load_dwordx4 v[72:75], v2, s[96:99], s95 offen nt
    s_add_u32 s3, s95, 0x1000
    buffer_load_dwordx4 v[76:79], v2, s[96:99], s3 offen nt
    v_dot2_f32_bf16 v22, v18, v14, 0
    v_dot2_f32_bf16 v23, v18, v16, 0
    v_dot2_f32_bf16 v24, v20, v14, 0
    v_dot2_f32_bf16 v25, v20, v16, 0
    v_dot2_f32_bf16 v22, v19, v15, v22
    v_dot2_f32_bf16 v23, v19, v17, v23
    v_dot2_f32_bf16 v24, v21, v15, v24
    v_dot2_f32_bf16 v25, v21, v17, v25
    s_nop 0
    v_permlane32_swap_b32 v22, v23
    v_add_f32 v26, v22, v23
    v_permlane32_swap_b32 v24, v25
    v_add_f32 v30, v24, v25
    s_waitcnt vmcnt(14)
    v_cvt_f32_i32 v80, v80
    v_cvt_f32_i32 v81, v81
    v_cvt_f32_i32 v82, v82
    v_cvt_f32_i32 v83, v83
    v_cvt_f32_i32 v84, v84
    v_cvt_f32_i32 v85, v85
    v_cvt_f32_i32 v86, v86
    v_cvt_f32_i32 v87, v87
    v_sub_f32 v80, v80, v6
    v_sub_f32 v81, v81, v7
    v_sub_f32 v82, v82, v8
    v_sub_f32 v83, v83, v9
    v_sub_f32 v84, v84, v6
    v_sub_f32 v85, v85, v7
    v_sub_f32 v86, v86, v8
    v_sub_f32 v87, v87, v9
    v_cvt_pk_bf16_f32 v80, 0, v80
    v_cvt_pk_bf16_f32 v81, 0, v81
    v_cvt_pk_bf16_f32 v82, 0, v82
    v_cvt_pk_bf16_f32 v83, 0, v83
    v_cvt_pk_bf16_f32 v84, 0, v84
    v_cvt_pk_bf16_f32 v85, 0, v85
    v_cvt_pk_bf16_f32 v86, 0, v86
    v_cvt_pk_bf16_f32 v87, 0, v87
    v_mul_f32 v80, v80, v10
    v_mul_f32 v81, v81, v11
    v_mul_f32 v82, v82, v12
    v_mul_f32 v83, v83, v13
    v_mul_f32 v84, v84, v10
    v_mul_f32 v85, v85, v11
    v_mul_f32 v86, v86, v12
    v_mul_f32 v87, v87, v13
    v_cvt_pk_bf16_f32 v18, v80, v81
    v_cvt_pk_bf16_f32 v19, v82, v83
    v_cvt_pk_bf16_f32 v20, v84, v85
    v_cvt_pk_bf16_f32 v21, v86, v87
    s_add_u32 s3, s95, 0x2000
    buffer_load_dwordx4 v[80:83], v2, s[96:99], s3 offen nt
    s_add_u32 s3, s95, 0x3000
    buffer_load_dwordx4 v[84:87], v2, s[96:99], s3 offen nt
    v_dot2_f32_bf16 v22, v18, v14, 0
    v_dot2_f32_bf16 v23, v18, v16, 0
    v_dot2_f32_bf16 v24, v20, v14, 0
    v_dot2_f32_bf16 v25, v20, v16, 0
    v_dot2_f32_bf16 v22, v19, v15, v22
    v_dot2_f32_bf16 v23, v19, v17, v23
    v_dot2_f32_bf16 v24, v21, v15, v24
    v_dot2_f32_bf16 v25, v21, v17, v25
    s_nop 0
    v_permlane32_swap_b32 v22, v23
    v_add_f32 v27, v22, v23
    s_nop 1
    v_permlane16_swap_b32 v26, v27
    v_add_f32 v28, v26, v27
    v_permlane32_swap_b32 v24, v25
    v_add_f32 v31, v24, v25
    s_nop 1
    v_permlane16_swap_b32 v30, v31
    v_add_f32 v32, v30, v31
    s_waitcnt vmcnt(14)
    v_cvt_f32_i32 v88, v88
    v_cvt_f32_i32 v89, v89
    v_cvt_f32_i32 v90, v90
    v_cvt_f32_i32 v91, v91
    v_cvt_f32_i32 v92, v92
    v_cvt_f32_i32 v93, v93
    v_cvt_f32_i32 v94, v94
    v_cvt_f32_i32 v95, v95
    v_sub_f32 v88, v88, v6
    v_sub_f32 v89, v89, v7
    v_sub_f32 v90, v90, v8
    v_sub_f32 v91, v91, v9
    v_sub_f32 v92, v92, v6
    v_sub_f32 v93, v93, v7
    v_sub_f32 v94, v94, v8
    v_sub_f32 v95, v95, v9
    v_cvt_pk_bf16_f32 v88, 0, v88
    v_cvt_pk_bf16_f32 v89, 0, v89
    v_cvt_pk_bf16_f32 v90, 0, v90
    v_cvt_pk_bf16_f32 v91, 0, v91
    v_cvt_pk_bf16_f32 v92, 0, v92
    v_cvt_pk_bf16_f32 v93, 0, v93
    v_cvt_pk_bf16_f32 v94, 0, v94
    v_cvt_pk_bf16_f32 v95, 0, v95
    v_mul_f32 v88, v88, v10
    v_mul_f32 v89, v89, v11
    v_mul_f32 v90, v90, v12
    v_mul_f32 v91, v91, v13
    v_mul_f32 v92, v92, v10
    v_mul_f32 v93, v93, v11
    v_mul_f32 v94, v94, v12
    v_mul_f32 v95, v95, v13
    v_cvt_pk_bf16_f32 v18, v88, v89
    v_cvt_pk_bf16_f32 v19, v90, v91
    v_cvt_pk_bf16_f32 v20, v92, v93
    v_cvt_pk_bf16_f32 v21, v94, v95
    s_add_u32 s3, s95, 0x4000
    buffer_load_dwordx4 v[88:91], v2, s[96:99], s3 offen nt
    s_add_u32 s3, s95, 0x5000
    buffer_load_dwordx4 v[92:95], v2, s[96:99], s3 offen nt
    v_dot2_f32_bf16 v22, v18, v14, 0
    v_dot2_f32_bf16 v23, v18, v16, 0
    v_dot2_f32_bf16 v24, v20, v14, 0
    v_dot2_f32_bf16 v25, v20, v16, 0
    v_dot2_f32_bf16 v22, v19, v15, v22
    v_dot2_f32_bf16 v23, v19, v17, v23
    v_dot2_f32_bf16 v24, v21, v15, v24
    v_dot2_f32_bf16 v25, v21, v17, v25
    s_nop 0
    v_permlane32_swap_b32 v22, v23
    v_add_f32 v26, v22, v23
    v_permlane32_swap_b32 v24, v25
    v_add_f32 v30, v24, v25
    s_waitcnt vmcnt(14)
    v_cvt_f32_i32 v96, v96
    v_cvt_f32_i32 v97, v97
    v_cvt_f32_i32 v98, v98
    v_cvt_f32_i32 v99, v99
    v_cvt_f32_i32 v100, v100
    v_cvt_f32_i32 v101, v101
    v_cvt_f32_i32 v102, v102
    v_cvt_f32_i32 v103, v103
    v_sub_f32 v96, v96, v6
    v_sub_f32 v97, v97, v7
    v_sub_f32 v98, v98, v8
    v_sub_f32 v99, v99, v9
    v_sub_f32 v100, v100, v6
    v_sub_f32 v101, v101, v7
    v_sub_f32 v102, v102, v8
    v_sub_f32 v103, v103, v9
    v_cvt_pk_bf16_f32 v96, 0, v96
    v_cvt_pk_bf16_f32 v97, 0, v97
    v_cvt_pk_bf16_f32 v98, 0, v98
    v_cvt_pk_bf16_f32 v99, 0, v99
    v_cvt_pk_bf16_f32 v100, 0, v100
    v_cvt_pk_bf16_f32 v101, 0, v101
    v_cvt_pk_bf16_f32 v102, 0, v102
    v_cvt_pk_bf16_f32 v103, 0, v103
    v_mul_f32 v96, v96, v10
    v_mul_f32 v97, v97, v11
    v_mul_f32 v98, v98, v12
    v_mul_f32 v99, v99, v13
    v_mul_f32 v100, v100, v10
    v_mul_f32 v101, v101, v11
    v_mul_f32 v102, v102, v12
    v_mul_f32 v103, v103, v13
    v_cvt_pk_bf16_f32 v18, v96, v97
    v_cvt_pk_bf16_f32 v19, v98, v99
    v_cvt_pk_bf16_f32 v20, v100, v101
    v_cvt_pk_bf16_f32 v21, v102, v103
    s_add_u32 s3, s95, 0x6000
    buffer_load_dwordx4 v[96:99], v2, s[96:99], s3 offen nt
    s_add_u32 s3, s95, 0x7000
    buffer_load_dwordx4 v[100:103], v2, s[96:99], s3 offen nt
    v_dot2_f32_bf16 v22, v18, v14, 0
    v_dot2_f32_bf16 v23, v18, v16, 0
    v_dot2_f32_bf16 v24, v20, v14, 0
    v_dot2_f32_bf16 v25, v20, v16, 0
    v_dot2_f32_bf16 v22, v19, v15, v22
    v_dot2_f32_bf16 v23, v19, v17, v23
    v_dot2_f32_bf16 v24, v21, v15, v24
    v_dot2_f32_bf16 v25, v21, v17, v25
    s_nop 0
    v_permlane32_swap_b32 v22, v23
    v_add_f32 v27, v22, v23
    s_nop 1
    v_permlane16_swap_b32 v26, v27
    v_add_f32 v27, v26, v27
    v_add_f32_dpp v28, v28, v28 row_ror:8 row_mask:0xf bank_mask:0x3
    s_nop 1
    v_add_f32_dpp v28, v27, v27 row_ror:8 row_mask:0xf bank_mask:0xc
    v_permlane32_swap_b32 v24, v25
    v_add_f32 v31, v24, v25
    s_nop 1
    v_permlane16_swap_b32 v30, v31
    v_add_f32 v31, v30, v31
    v_add_f32_dpp v32, v32, v32 row_ror:8 row_mask:0xf bank_mask:0x3
    s_nop 1
    v_add_f32_dpp v32, v31, v31 row_ror:8 row_mask:0xf bank_mask:0xc
    s_waitcnt vmcnt(14)
    v_cvt_f32_i32 v104, v104
    v_cvt_f32_i32 v105, v105
    v_cvt_f32_i32 v106, v106
    v_cvt_f32_i32 v107, v107
    v_cvt_f32_i32 v108, v108
    v_cvt_f32_i32 v109, v109
    v_cvt_f32_i32 v110, v110
    v_cvt_f32_i32 v111, v111
    v_sub_f32 v104, v104, v6
    v_sub_f32 v105, v105, v7
    v_sub_f32 v106, v106, v8
    v_sub_f32 v107, v107, v9
    v_sub_f32 v108, v108, v6
    v_sub_f32 v109, v109, v7
    v_sub_f32 v110, v110, v8
    v_sub_f32 v111, v111, v9
    v_cvt_pk_bf16_f32 v104, 0, v104
    v_cvt_pk_bf16_f32 v105, 0, v105
    v_cvt_pk_bf16_f32 v106, 0, v106
    v_cvt_pk_bf16_f32 v107, 0, v107
    v_cvt_pk_bf16_f32 v108, 0, v108
    v_cvt_pk_bf16_f32 v109, 0, v109
    v_cvt_pk_bf16_f32 v110, 0, v110
    v_cvt_pk_bf16_f32 v111, 0, v111
    v_mul_f32 v104, v104, v10
    v_mul_f32 v105, v105, v11
    v_mul_f32 v106, v106, v12
    v_mul_f32 v107, v107, v13
    v_mul_f32 v108, v108, v10
    v_mul_f32 v109, v109, v11
    v_mul_f32 v110, v110, v12
    v_mul_f32 v111, v111, v13
    v_cvt_pk_bf16_f32 v18, v104, v105
    v_cvt_pk_bf16_f32 v19, v106, v107
    v_cvt_pk_bf16_f32 v20, v108, v109
    v_cvt_pk_bf16_f32 v21, v110, v111
    s_add_u32 s3, s95, 0x8000
    buffer_load_dwordx4 v[104:107], v2, s[96:99], s3 offen nt
    s_add_u32 s3, s95, 0x9000
    buffer_load_dwordx4 v[108:111], v2, s[96:99], s3 offen nt
    v_dot2_f32_bf16 v22, v18, v14, 0
    v_dot2_f32_bf16 v23, v18, v16, 0
    v_dot2_f32_bf16 v24, v20, v14, 0
    v_dot2_f32_bf16 v25, v20, v16, 0
    v_dot2_f32_bf16 v22, v19, v15, v22
    v_dot2_f32_bf16 v23, v19, v17, v23
    v_dot2_f32_bf16 v24, v21, v15, v24
    v_dot2_f32_bf16 v25, v21, v17, v25
    s_nop 0
    v_permlane32_swap_b32 v22, v23
    v_add_f32 v26, v22, v23
    v_permlane32_swap_b32 v24, v25
    v_add_f32 v30, v24, v25
    s_waitcnt vmcnt(14)
    v_cvt_f32_i32 v112, v112
    v_cvt_f32_i32 v113, v113
    v_cvt_f32_i32 v114, v114
    v_cvt_f32_i32 v115, v115
    v_cvt_f32_i32 v116, v116
    v_cvt_f32_i32 v117, v117
    v_cvt_f32_i32 v118, v118
    v_cvt_f32_i32 v119, v119
    v_sub_f32 v112, v112, v6
    v_sub_f32 v113, v113, v7
    v_sub_f32 v114, v114, v8
    v_sub_f32 v115, v115, v9
    v_sub_f32 v116, v116, v6
    v_sub_f32 v117, v117, v7
    v_sub_f32 v118, v118, v8
    v_sub_f32 v119, v119, v9
    v_cvt_pk_bf16_f32 v112, 0, v112
    v_cvt_pk_bf16_f32 v113, 0, v113
    v_cvt_pk_bf16_f32 v114, 0, v114
    v_cvt_pk_bf16_f32 v115, 0, v115
    v_cvt_pk_bf16_f32 v116, 0, v116
    v_cvt_pk_bf16_f32 v117, 0, v117
    v_cvt_pk_bf16_f32 v118, 0, v118
    v_cvt_pk_bf16_f32 v119, 0, v119
    v_mul_f32 v112, v112, v10
    v_mul_f32 v113, v113, v11
    v_mul_f32 v114, v114, v12
    v_mul_f32 v115, v115, v13
    v_mul_f32 v116, v116, v10
    v_mul_f32 v117, v117, v11
    v_mul_f32 v118, v118, v12
    v_mul_f32 v119, v119, v13
    v_cvt_pk_bf16_f32 v18, v112, v113
    v_cvt_pk_bf16_f32 v19, v114, v115
    v_cvt_pk_bf16_f32 v20, v116, v117
    v_cvt_pk_bf16_f32 v21, v118, v119
    s_add_u32 s3, s95, 0xa000
    buffer_load_dwordx4 v[112:115], v2, s[96:99], s3 offen nt
    s_add_u32 s3, s95, 0xb000
    buffer_load_dwordx4 v[116:119], v2, s[96:99], s3 offen nt
    v_dot2_f32_bf16 v22, v18, v14, 0
    v_dot2_f32_bf16 v23, v18, v16, 0
    v_dot2_f32_bf16 v24, v20, v14, 0
    v_dot2_f32_bf16 v25, v20, v16, 0
    v_dot2_f32_bf16 v22, v19, v15, v22
    v_dot2_f32_bf16 v23, v19, v17, v23
    v_dot2_f32_bf16 v24, v21, v15, v24
    v_dot2_f32_bf16 v25, v21, v17, v25
    s_nop 0
    v_permlane32_swap_b32 v22, v23
    v_add_f32 v27, v22, v23
    s_nop 1
    v_permlane16_swap_b32 v26, v27
    v_add_f32 v29, v26, v27
    v_permlane32_swap_b32 v24, v25
    v_add_f32 v31, v24, v25
    s_nop 1
    v_permlane16_swap_b32 v30, v31
    v_add_f32 v33, v30, v31
    s_waitcnt vmcnt(14)
    v_cvt_f32_i32 v120, v120
    v_cvt_f32_i32 v121, v121
    v_cvt_f32_i32 v122, v122
    v_cvt_f32_i32 v123, v123
    v_cvt_f32_i32 v124, v124
    v_cvt_f32_i32 v125, v125
    v_cvt_f32_i32 v126, v126
    v_cvt_f32_i32 v127, v127
    v_sub_f32 v120, v120, v6
    v_sub_f32 v121, v121, v7
    v_sub_f32 v122, v122, v8
    v_sub_f32 v123, v123, v9
    v_sub_f32 v124, v124, v6
    v_sub_f32 v125, v125, v7
    v_sub_f32 v126, v126, v8
    v_sub_f32 v127, v127, v9
    v_cvt_pk_bf16_f32 v120, 0, v120
    v_cvt_pk_bf16_f32 v121, 0, v121
    v_cvt_pk_bf16_f32 v122, 0, v122
    v_cvt_pk_bf16_f32 v123, 0, v123
    v_cvt_pk_bf16_f32 v124, 0, v124
    v_cvt_pk_bf16_f32 v125, 0, v125
    v_cvt_pk_bf16_f32 v126, 0, v126
    v_cvt_pk_bf16_f32 v127, 0, v127
    v_mul_f32 v120, v120, v10
    v_mul_f32 v121, v121, v11
    v_mul_f32 v122, v122, v12
    v_mul_f32 v123, v123, v13
    v_mul_f32 v124, v124, v10
    v_mul_f32 v125, v125, v11
    v_mul_f32 v126, v126, v12
    v_mul_f32 v127, v127, v13
    v_cvt_pk_bf16_f32 v18, v120, v121
    v_cvt_pk_bf16_f32 v19, v122, v123
    v_cvt_pk_bf16_f32 v20, v124, v125
    v_cvt_pk_bf16_f32 v21, v126, v127
    s_add_u32 s3, s95, 0xc000
    buffer_load_dwordx4 v[120:123], v2, s[96:99], s3 offen nt
    s_add_u32 s3, s95, 0xd000
    buffer_load_dwordx4 v[124:127], v2, s[96:99], s3 offen nt
    v_dot2_f32_bf16 v22, v18, v14, 0
    v_dot2_f32_bf16 v23, v18, v16, 0
    v_dot2_f32_bf16 v24, v20, v14, 0
    v_dot2_f32_bf16 v25, v20, v16, 0
    v_dot2_f32_bf16 v22, v19, v15, v22
    v_dot2_f32_bf16 v23, v19, v17, v23
    v_dot2_f32_bf16 v24, v21, v15, v24
    v_dot2_f32_bf16 v25, v21, v17, v25
    s_nop 0
    v_permlane32_swap_b32 v22, v23
    v_add_f32 v26, v22, v23
    v_permlane32_swap_b32 v24, v25
    v_add_f32 v30, v24, v25
    s_waitcnt vmcnt(14)
    v_cvt_f32_i32 v128, v128
    v_cvt_f32_i32 v129, v129
    v_cvt_f32_i32 v130, v130
    v_cvt_f32_i32 v131, v131
    v_cvt_f32_i32 v132, v132
    v_cvt_f32_i32 v133, v133
    v_cvt_f32_i32 v134, v134
    v_cvt_f32_i32 v135, v135
    v_sub_f32 v128, v128, v6
    v_sub_f32 v129, v129, v7
    v_sub_f32 v130, v130, v8
    v_sub_f32 v131, v131, v9
    v_sub_f32 v132, v132, v6
    v_sub_f32 v133, v133, v7
    v_sub_f32 v134, v134, v8
    v_sub_f32 v135, v135, v9
    v_cvt_pk_bf16_f32 v128, 0, v128
    v_cvt_pk_bf16_f32 v129, 0, v129
    v_cvt_pk_bf16_f32 v130, 0, v130
    v_cvt_pk_bf16_f32 v131, 0, v131
    v_cvt_pk_bf16_f32 v132, 0, v132
    v_cvt_pk_bf16_f32 v133, 0, v133
    v_cvt_pk_bf16_f32 v134, 0, v134
    v_cvt_pk_bf16_f32 v135, 0, v135
    v_mul_f32 v128, v128, v10
    v_mul_f32 v129, v129, v11
    v_mul_f32 v130, v130, v12
    v_mul_f32 v131, v131, v13
    v_mul_f32 v132, v132, v10
    v_mul_f32 v133, v133, v11
    v_mul_f32 v134, v134, v12
    v_mul_f32 v135, v135, v13
    v_cvt_pk_bf16_f32 v18, v128, v129
    v_cvt_pk_bf16_f32 v19, v130, v131
    v_cvt_pk_bf16_f32 v20, v132, v133
    v_cvt_pk_bf16_f32 v21, v134, v135
    s_add_u32 s3, s95, 0xe000
    buffer_load_dwordx4 v[128:131], v2, s[96:99], s3 offen nt
    s_add_u32 s3, s95, 0xf000
    buffer_load_dwordx4 v[132:135], v2, s[96:99], s3 offen nt
    v_dot2_f32_bf16 v22, v18, v14, 0
    v_dot2_f32_bf16 v23, v18, v16, 0
    v_dot2_f32_bf16 v24, v20, v14, 0
    v_dot2_f32_bf16 v25, v20, v16, 0
    v_dot2_f32_bf16 v22, v19, v15, v22
    v_dot2_f32_bf16 v23, v19, v17, v23
    v_dot2_f32_bf16 v24, v21, v15, v24
    v_dot2_f32_bf16 v25, v21, v17, v25
    s_nop 0
    v_permlane32_swap_b32 v22, v23
    v_add_f32 v27, v22, v23
    s_nop 1
    v_permlane16_swap_b32 v26, v27
    v_add_f32 v27, v26, v27
    v_add_f32_dpp v29, v29, v29 row_ror:8 row_mask:0xf bank_mask:0x3
    s_nop 1
    v_add_f32_dpp v29, v27, v27 row_ror:8 row_mask:0xf bank_mask:0xc
    v_add_f32_dpp v28, v28, v28 row_half_mirror row_mask:0xf bank_mask:0x5
    s_nop 1
    v_add_f32_dpp v28, v29, v29 row_half_mirror row_mask:0xf bank_mask:0xa
    s_nop 1
    v_add_f32_dpp v28, v28, v28 quad_perm:[1,0,3,2] row_mask:0xf bank_mask:0xf
    s_nop 1
    v_add_f32_dpp v28, v28, v28 quad_perm:[2,3,0,1] row_mask:0xf bank_mask:0xf
    v_permlane32_swap_b32 v24, v25
    v_add_f32 v31, v24, v25
    s_nop 1
    v_permlane16_swap_b32 v30, v31
    v_add_f32 v31, v30, v31
    v_add_f32_dpp v33, v33, v33 row_ror:8 row_mask:0xf bank_mask:0x3
    s_nop 1
    v_add_f32_dpp v33, v31, v31 row_ror:8 row_mask:0xf bank_mask:0xc
    v_add_f32_dpp v32, v32, v32 row_half_mirror row_mask:0xf bank_mask:0x5
    s_nop 1
    v_add_f32_dpp v32, v33, v33 row_half_mirror row_mask:0xf bank_mask:0xa
    s_nop 1
    v_add_f32_dpp v32, v32, v32 quad_perm:[1,0,3,2] row_mask:0xf bank_mask:0xf
    s_nop 1
    v_add_f32_dpp v32, v32, v32 quad_perm:[2,3,0,1] row_mask:0xf bank_mask:0xf
    v_cndmask_b32 v34, v34, v28, s[36:37]
    v_cndmask_b32 v35, v35, v32, s[36:37]
    s_lshl_b64 s[36:37], s[36:37], 1
    s_cmp_lg_u32 s32, 2
    s_cbranch_scc1 L_nosw
    v_lshlrev_b32 v6, 16, v62
    v_and_b32 v7, 0xffff0000, v62
    v_lshlrev_b32 v8, 16, v63
    v_and_b32 v9, 0xffff0000, v63
    v_lshlrev_b32 v10, 16, v66
    v_and_b32 v11, 0xffff0000, v66
    v_lshlrev_b32 v12, 16, v67
    v_and_b32 v13, 0xffff0000, v67
    s_nop 4
L_nosw:
    s_cmp_lt_u32 s32, s34
    s_cbranch_scc1 L_kloop
    s_lshl_b32 s38, s29, 2
    s_add_u32 s38, s38, 8704
    v_mov_b32 v68, s38
    s_xor_b32 s29, s29, 1
    s_barrier
    ds_read_b32 v69, v68
    v_cvt_pk_bf16_f32 v34, 0, v34
    v_cvt_pk_bf16_f32 v35, 0, v35
    v_max3_f32 v44, v34, v35, v53
    s_nop 1
    v_max_f32_dpp v44, v44, v44 quad_perm:[1,0,3,2] row_mask:0xf bank_mask:0xf
    s_nop 1
    v_max_f32_dpp v44, v44, v44 quad_perm:[2,3,0,1] row_mask:0xf bank_mask:0xf
    s_nop 1
    v_max_f32_dpp v44, v44, v44 row_half_mirror row_mask:0xf bank_mask:0xf
    s_nop 1
    v_max_f32_dpp v44, v44, v44 row_mirror row_mask:0xf bank_mask:0xf
    v_mov_b32 v45, v44
    s_nop 1
    v_permlane16_swap_b32 v44, v45
    v_max_f32 v44, v44, v45
    v_sub_f32 v48, v53, v44
    v_mov_b32 v53, v44
    v_sub_f32 v46, v34, v53
    v_sub_f32 v47, v35, v53
    v_mul_f32 v48, s92, v48
    v_mul_f32 v46, s92, v46
    v_mul_f32 v47, s92, v47
    v_exp_f32 v48, v48
    v_exp_f32 v46, v46
    v_exp_f32 v47, v47
    s_nop 0
    v_add_f32 v44, v46, v47
    v_cvt_pk_bf16_f32 v52, v46, v47
    v_readlane_b32 s40, v48, 0
    v_readlane_b32 s41, v48, 32
    v_add_f32_dpp v44, v44, v44 quad_perm:[1,0,3,2] row_mask:0xf bank_mask:0xf
    s_nop 1
    v_add_f32_dpp v44, v44, v44 quad_perm:[2,3,0,1] row_mask:0xf bank_mask:0xf
    s_nop 1
    v_add_f32_dpp v44, v44, v44 row_half_mirror row_mask:0xf bank_mask:0xf
    s_nop 1
    v_add_f32_dpp v44, v44, v44 row_mirror row_mask:0xf bank_mask:0xf
    v_mov_b32 v45, v44
    s_nop 1
    v_permlane16_swap_b32 v44, v45
    v_add_f32 v44, v44, v45
    v_fma_f32 v54, v54, v48, v44
    v_mul_f32 v36, s40, v36
    v_mul_f32 v37, s40, v37
    v_mul_f32 v38, s40, v38
    v_mul_f32 v39, s40, v39
    v_mul_f32 v40, s41, v40
    v_mul_f32 v41, s41, v41
    v_mul_f32 v42, s41, v42
    v_mul_f32 v43, s41, v43
    s_waitcnt lgkmcnt(0)
    v_readfirstlane_b32 s38, v69
    s_nop 1
    s_cmp_ge_u32 s38, 36
    s_cselect_b32 s3, 1, 0
    s_and_b32 s35, s38, 3
    s_lshr_b32 s38, s38, 2
    s_lshl_b32 s94, s38, 3
    s_mov_b32 s93, 4
    s_lshl_b32 s39, s38, 2
    s_add_u32 s39, s39, 8
    s_cmp_ge_u32 s38, 2
    s_cselect_b32 s94, s39, s94
    s_cselect_b32 s93, 2, s93
    s_lshl_b32 s39, s38, 1
    s_add_u32 s39, s39, 14
    s_cmp_ge_u32 s38, 3
    s_cselect_b32 s94, s39, s94
    s_cselect_b32 s93, 1, s93
    s_add_u32 s39, s38, 23
    s_cmp_ge_u32 s38, 9
    s_cselect_b32 s94, s39, s94
    s_cselect_b32 s39, 1, 0
    s_mul_i32 s35, s35, 32
    s_add_u32 s94, s94, s35
    s_cmp_eq_u32 s3, 1
    s_cselect_b32 s93, 0, s93
    s_cselect_b32 s94, 0, s94
    s_lshl_b32 s35, s28, 7
    s_add_u32 s94, s35, s94
    s_lshl_b32 s35, s94, 15
    s_add_u32 s88, s35, 0x8000
    s_cmp_eq_u32 s39, 1
    s_cselect_b32 s88, s88, 0x10000000
    s_mov_b32 s89, 0x11111111
    s_cselect_b32 s89, 0x01010101, s89
    s_cmp_eq_u32 s93, 0
    s_cselect_b32 s88, 0, s88
    s_cmp_eq_u32 s93, 0
    s_cbranch_scc1 L_nonext
    s_lshr_b32 s38, s94, 2
    s_lshl_b32 s38, s38, 9
    v_add_u32 v68, s38, v4
    s_cmp_eq_u32 s93, 4
    s_cselect_b32 s38, 0x200, 0
    v_add_u32 v69, s38, v68
    global_load_dwordx2 v[60:61], v68, s[12:13]
    global_load_dwordx2 v[62:63], v69, s[12:13]
    global_load_dwordx2 v[64:65], v68, s[10:11]
    global_load_dwordx2 v[66:67], v69, s[10:11]
    s_lshl_b32 s38, s94, 6
    v_add_u32 v68, s38, v5
    v_min_u32 v68, 0x7fff6, v68
    global_load_ushort v57, v68, s[16:17]
    global_load_ushort v58, v68, s[14:15]
    global_load_ushort v59, v68, s[16:17] offset:8
    global_load_ushort v70, v68, s[14:15] offset:8
    s_nop 0
L_nonext:
    s_mov_b32 s32, 0
L_vloop:
    s_lshl_b32 s31, s32, 16
    s_add_u32 s31, s31, s30
    s_mov_b32 s24, s8
    s_mov_b32 s25, s9
    s_mov_b32 s26, s90
    s_add_u32 s95, s31, 0x10000
    s_add_u32 s32, s32, 1
    s_cmp_lt_u32 s32, s34
    s_cselect_b32 s96, s8, s6
    s_cselect_b32 s97, s9, s7
    s_cselect_b32 s95, s95, s35
    s_cselect_b32 s98, s90, s88
    v_readlane_b32 s42, v55, 0
    v_readlane_b32 s43, v56, 0
    v_readlane_b32 s40, v52, 0
    v_readlane_b32 s41, v52, 32
    s_lshl_b32 s44, s42, 16
    s_and_b32 s45, s42, 0xffff0000
    s_lshl_b32 s46, s43, 16
    s_and_b32 s47, s43, 0xffff0000
    s_waitcnt vmcnt(14)
    v_cvt_f32_i32 v72, v72
    v_cvt_f32_i32 v73, v73
    v_cvt_f32_i32 v74, v74
    v_cvt_f32_i32 v75, v75
    v_cvt_f32_i32 v76, v76
    v_cvt_f32_i32 v77, v77
    v_cvt_f32_i32 v78, v78
    v_cvt_f32_i32 v79, v79
    v_subrev_f32 v72, s44, v72
    v_subrev_f32 v73, s44, v73
    v_subrev_f32 v74, s44, v74
    v_subrev_f32 v75, s44, v75
    v_subrev_f32 v76, s46, v76
    v_subrev_f32 v77, s46, v77
    v_subrev_f32 v78, s46, v78
    v_subrev_f32 v79, s46, v79
    v_cvt_pk_bf16_f32 v72, 0, v72
    v_cvt_pk_bf16_f32 v73, 0, v73
    v_cvt_pk_bf16_f32 v74, 0, v74
    v_cvt_pk_bf16_f32 v75, 0, v75
    v_cvt_pk_bf16_f32 v76, 0, v76
    v_cvt_pk_bf16_f32 v77, 0, v77
    v_cvt_pk_bf16_f32 v78, 0, v78
    v_cvt_pk_bf16_f32 v79, 0, v79
    v_mul_f32 v72, s45, v72
    v_mul_f32 v73, s45, v73
    v_mul_f32 v74, s45, v74
    v_mul_f32 v75, s45, v75
    v_mul_f32 v76, s47, v76
    v_mul_f32 v77, s47, v77
    v_mul_f32 v78, s47, v78
    v_mul_f32 v79, s47, v79
    v_cvt_pk_bf16_f32 v18, v72, v76
    v_cvt_pk_bf16_f32 v19, v73, v77
    v_cvt_pk_bf16_f32 v20, v74, v78
    v_cvt_pk_bf16_f32 v21, v75, v79
    buffer_load_dwordx4 v[72:75], v2, s[96:99], s95 offen nt
    s_add_u32 s3, s95, 0x1000
    buffer_load_dwordx4 v[76:79], v2, s[96:99], s3 offen nt
    v_dot2c_f32_bf16 v36, s40, v18
    v_dot2c_f32_bf16 v37, s40, v19
    v_dot2c_f32_bf16 v38, s40, v20
    v_dot2c_f32_bf16 v39, s40, v21
    v_dot2c_f32_bf16 v40, s41, v18
    v_dot2c_f32_bf16 v41, s41, v19
    v_dot2c_f32_bf16 v42, s41, v20
    v_dot2c_f32_bf16 v43, s41, v21
    v_readlane_b32 s50, v55, 16
    v_readlane_b32 s51, v56, 16
    v_readlane_b32 s48, v52, 16
    v_readlane_b32 s49, v52, 48
    s_lshl_b32 s52, s50, 16
    s_and_b32 s53, s50, 0xffff0000
    s_lshl_b32 s54, s51, 16
    s_and_b32 s55, s51, 0xffff0000
    s_waitcnt vmcnt(14)
    v_cvt_f32_i32 v80, v80
    v_cvt_f32_i32 v81, v81
    v_cvt_f32_i32 v82, v82
    v_cvt_f32_i32 v83, v83
    v_cvt_f32_i32 v84, v84
    v_cvt_f32_i32 v85, v85
    v_cvt_f32_i32 v86, v86
    v_cvt_f32_i32 v87, v87
    v_subrev_f32 v80, s52, v80
    v_subrev_f32 v81, s52, v81
    v_subrev_f32 v82, s52, v82
    v_subrev_f32 v83, s52, v83
    v_subrev_f32 v84, s54, v84
    v_subrev_f32 v85, s54, v85
    v_subrev_f32 v86, s54, v86
    v_subrev_f32 v87, s54, v87
    v_cvt_pk_bf16_f32 v80, 0, v80
    v_cvt_pk_bf16_f32 v81, 0, v81
    v_cvt_pk_bf16_f32 v82, 0, v82
    v_cvt_pk_bf16_f32 v83, 0, v83
    v_cvt_pk_bf16_f32 v84, 0, v84
    v_cvt_pk_bf16_f32 v85, 0, v85
    v_cvt_pk_bf16_f32 v86, 0, v86
    v_cvt_pk_bf16_f32 v87, 0, v87
    v_mul_f32 v80, s53, v80
    v_mul_f32 v81, s53, v81
    v_mul_f32 v82, s53, v82
    v_mul_f32 v83, s53, v83
    v_mul_f32 v84, s55, v84
    v_mul_f32 v85, s55, v85
    v_mul_f32 v86, s55, v86
    v_mul_f32 v87, s55, v87
    v_cvt_pk_bf16_f32 v18, v80, v84
    v_cvt_pk_bf16_f32 v19, v81, v85
    v_cvt_pk_bf16_f32 v20, v82, v86
    v_cvt_pk_bf16_f32 v21, v83, v87
    s_add_u32 s3, s95, 0x2000
    buffer_load_dwordx4 v[80:83], v2, s[96:99], s3 offen nt
    s_add_u32 s3, s95, 0x3000
    buffer_load_dwordx4 v[84:87], v2, s[96:99], s3 offen nt
    v_dot2c_f32_bf16 v36, s48, v18
    v_dot2c_f32_bf16 v37, s48, v19
    v_dot2c_f32_bf16 v38, s48, v20
    v_dot2c_f32_bf16 v39, s48, v21
    v_dot2c_f32_bf16 v40, s49, v18
    v_dot2c_f32_bf16 v41, s49, v19
    v_dot2c_f32_bf16 v42, s49, v20
    v_dot2c_f32_bf16 v43, s49, v21
    v_readlane_b32 s42, v55, 8
    v_readlane_b32 s43, v56, 8
    v_readlane_b32 s40, v52, 8
    v_readlane_b32 s41, v52, 40
    s_lshl_b32 s44, s42, 16
    s_and_b32 s45, s42, 0xffff0000
    s_lshl_b32 s46, s43, 16
    s_and_b32 s47, s43, 0xffff0000
    s_waitcnt vmcnt(14)
    v_cvt_f32_i32 v88, v88
    v_cvt_f32_i32 v89, v89
    v_cvt_f32_i32 v90, v90
    v_cvt_f32_i32 v91, v91
    v_cvt_f32_i32 v92, v92
    v_cvt_f32_i32 v93, v93
    v_cvt_f32_i32 v94, v94
    v_cvt_f32_i32 v95, v95
    v_subrev_f32 v88, s44, v88
    v_subrev_f32 v89, s44, v89
    v_subrev_f32 v90, s44, v90
    v_subrev_f32 v91, s44, v91
    v_subrev_f32 v92, s46, v92
    v_subrev_f32 v93, s46, v93
    v_subrev_f32 v94, s46, v94
    v_subrev_f32 v95, s46, v95
    v_cvt_pk_bf16_f32 v88, 0, v88
    v_cvt_pk_bf16_f32 v89, 0, v89
    v_cvt_pk_bf16_f32 v90, 0, v90
    v_cvt_pk_bf16_f32 v91, 0, v91
    v_cvt_pk_bf16_f32 v92, 0, v92
    v_cvt_pk_bf16_f32 v93, 0, v93
    v_cvt_pk_bf16_f32 v94, 0, v94
    v_cvt_pk_bf16_f32 v95, 0, v95
    v_mul_f32 v88, s45, v88
    v_mul_f32 v89, s45, v89
    v_mul_f32 v90, s45, v90
    v_mul_f32 v91, s45, v91
    v_mul_f32 v92, s47, v92
    v_mul_f32 v93, s47, v93
    v_mul_f32 v94, s47, v94
    v_mul_f32 v95, s47, v95
    v_cvt_pk_bf16_f32 v18, v88, v92
    v_cvt_pk_bf16_f32 v19, v89, v93
    v_cvt_pk_bf16_f32 v20, v90, v94
    v_cvt_pk_bf16_f32 v21, v91, v95
    s_add_u32 s3, s95, 0x4000
    buffer_load_dwordx4 v[88:91], v2, s[96:99], s3 offen nt
    s_add_u32 s3, s95, 0x5000
    buffer_load_dwordx4 v[92:95], v2, s[96:99], s3 offen nt
    v_dot2c_f32_bf16 v36, s40, v18
    v_dot2c_f32_bf16 v37, s40, v19
    v_dot2c_f32_bf16 v38, s40, v20
    v_dot2c_f32_bf16 v39, s40, v21
    v_dot2c_f32_bf16 v40, s41, v18
    v_dot2c_f32_bf16 v41, s41, v19
    v_dot2c_f32_bf16 v42, s41, v20
    v_dot2c_f32_bf16 v43, s41, v21
    v_readlane_b32 s50, v55, 24
    v_readlane_b32 s51, v56, 24
    v_readlane_b32 s48, v52, 24
    v_readlane_b32 s49, v52, 56
    s_lshl_b32 s52, s50, 16
    s_and_b32 s53, s50, 0xffff0000
    s_lshl_b32 s54, s51, 16
    s_and_b32 s55, s51, 0xffff0000
    s_waitcnt vmcnt(14)
    v_cvt_f32_i32 v96, v96
    v_cvt_f32_i32 v97, v97
    v_cvt_f32_i32 v98, v98
    v_cvt_f32_i32 v99, v99
    v_cvt_f32_i32 v100, v100
    v_cvt_f32_i32 v101, v101
    v_cvt_f32_i32 v102, v102
    v_cvt_f32_i32 v103, v103
    v_subrev_f32 v96, s52, v96
    v_subrev_f32 v97, s52, v97
    v_subrev_f32 v98, s52, v98
    v_subrev_f32 v99, s52, v99
    v_subrev_f32 v100, s54, v100
    v_subrev_f32 v101, s54, v101
    v_subrev_f32 v102, s54, v102
    v_subrev_f32 v103, s54, v103
    v_cvt_pk_bf16_f32 v96, 0, v96
    v_cvt_pk_bf16_f32 v97, 0, v97
    v_cvt_pk_bf16_f32 v98, 0, v98
    v_cvt_pk_bf16_f32 v99, 0, v99
    v_cvt_pk_bf16_f32 v100, 0, v100
    v_cvt_pk_bf16_f32 v101, 0, v101
    v_cvt_pk_bf16_f32 v102, 0, v102
    v_cvt_pk_bf16_f32 v103, 0, v103
    v_mul_f32 v96, s53, v96
    v_mul_f32 v97, s53, v97
    v_mul_f32 v98, s53, v98
    v_mul_f32 v99, s53, v99
    v_mul_f32 v100, s55, v100
    v_mul_f32 v101, s55, v101
    v_mul_f32 v102, s55, v102
    v_mul_f32 v103, s55, v103
    v_cvt_pk_bf16_f32 v18, v96, v100
    v_cvt_pk_bf16_f32 v19, v97, v101
    v_cvt_pk_bf16_f32 v20, v98, v102
    v_cvt_pk_bf16_f32 v21, v99, v103
    s_add_u32 s3, s95, 0x6000
    buffer_load_dwordx4 v[96:99], v2, s[96:99], s3 offen nt
    s_add_u32 s3, s95, 0x7000
    buffer_load_dwordx4 v[100:103], v2, s[96:99], s3 offen nt
    v_dot2c_f32_bf16 v36, s48, v18
    v_dot2c_f32_bf16 v37, s48, v19
    v_dot2c_f32_bf16 v38, s48, v20
    v_dot2c_f32_bf16 v39, s48, v21
    v_dot2c_f32_bf16 v40, s49, v18
    v_dot2c_f32_bf16 v41, s49, v19
    v_dot2c_f32_bf16 v42, s49, v20
    v_dot2c_f32_bf16 v43, s49, v21
    v_readlane_b32 s42, v55, 4
    v_readlane_b32 s43, v56, 4
    v_readlane_b32 s40, v52, 4
    v_readlane_b32 s41, v52, 36
    s_lshl_b32 s44, s42, 16
    s_and_b32 s45, s42, 0xffff0000
    s_lshl_b32 s46, s43, 16
    s_and_b32 s47, s43, 0xffff0000
    s_waitcnt vmcnt(14)
    v_cvt_f32_i32 v104, v104
    v_cvt_f32_i32 v105, v105
    v_cvt_f32_i32 v106, v106
    v_cvt_f32_i32 v107, v107
    v_cvt_f32_i32 v108, v108
    v_cvt_f32_i32 v109, v109
    v_cvt_f32_i32 v110, v110
    v_cvt_f32_i32 v111, v111
    v_subrev_f32 v104, s44, v104
    v_subrev_f32 v105, s44, v105
    v_subrev_f32 v106, s44, v106
    v_subrev_f32 v107, s44, v107
    v_subrev_f32 v108, s46, v108
    v_subrev_f32 v109, s46, v109
    v_subrev_f32 v110, s46, v110
    v_subrev_f32 v111, s46, v111
    v_cvt_pk_bf16_f32 v104, 0, v104
    v_cvt_pk_bf16_f32 v105, 0, v105
    v_cvt_pk_bf16_f32 v106, 0, v106
    v_cvt_pk_bf16_f32 v107, 0, v107
    v_cvt_pk_bf16_f32 v108, 0, v108
    v_cvt_pk_bf16_f32 v109, 0, v109
    v_cvt_pk_bf16_f32 v110, 0, v110
    v_cvt_pk_bf16_f32 v111, 0, v111
    v_mul_f32 v104, s45, v104
    v_mul_f32 v105, s45, v105
    v_mul_f32 v106, s45, v106
    v_mul_f32 v107, s45, v107
    v_mul_f32 v108, s47, v108
    v_mul_f32 v109, s47, v109
    v_mul_f32 v110, s47, v110
    v_mul_f32 v111, s47, v111
    v_cvt_pk_bf16_f32 v18, v104, v108
    v_cvt_pk_bf16_f32 v19, v105, v109
    v_cvt_pk_bf16_f32 v20, v106, v110
    v_cvt_pk_bf16_f32 v21, v107, v111
    s_add_u32 s3, s95, 0x8000
    buffer_load_dwordx4 v[104:107], v2, s[96:99], s3 offen nt
    s_add_u32 s3, s95, 0x9000
    buffer_load_dwordx4 v[108:111], v2, s[96:99], s3 offen nt
    v_dot2c_f32_bf16 v36, s40, v18
    v_dot2c_f32_bf16 v37, s40, v19
    v_dot2c_f32_bf16 v38, s40, v20
    v_dot2c_f32_bf16 v39, s40, v21
    v_dot2c_f32_bf16 v40, s41, v18
    v_dot2c_f32_bf16 v41, s41, v19
    v_dot2c_f32_bf16 v42, s41, v20
    v_dot2c_f32_bf16 v43, s41, v21
    v_readlane_b32 s50, v55, 20
    v_readlane_b32 s51, v56, 20
    v_readlane_b32 s48, v52, 20
    v_readlane_b32 s49, v52, 52
    s_lshl_b32 s52, s50, 16
    s_and_b32 s53, s50, 0xffff0000
    s_lshl_b32 s54, s51, 16
    s_and_b32 s55, s51, 0xffff0000
    s_waitcnt vmcnt(14)
    v_cvt_f32_i32 v112, v112
    v_cvt_f32_i32 v113, v113
    v_cvt_f32_i32 v114, v114
    v_cvt_f32_i32 v115, v115
    v_cvt_f32_i32 v116, v116
    v_cvt_f32_i32 v117, v117
    v_cvt_f32_i32 v118, v118
    v_cvt_f32_i32 v119, v119
    v_subrev_f32 v112, s52, v112
    v_subrev_f32 v113, s52, v113
    v_subrev_f32 v114, s52, v114
    v_subrev_f32 v115, s52, v115
    v_subrev_f32 v116, s54, v116
    v_subrev_f32 v117, s54, v117
    v_subrev_f32 v118, s54, v118
    v_subrev_f32 v119, s54, v119
    v_cvt_pk_bf16_f32 v112, 0, v112
    v_cvt_pk_bf16_f32 v113, 0, v113
    v_cvt_pk_bf16_f32 v114, 0, v114
    v_cvt_pk_bf16_f32 v115, 0, v115
    v_cvt_pk_bf16_f32 v116, 0, v116
    v_cvt_pk_bf16_f32 v117, 0, v117
    v_cvt_pk_bf16_f32 v118, 0, v118
    v_cvt_pk_bf16_f32 v119, 0, v119
    v_mul_f32 v112, s53, v112
    v_mul_f32 v113, s53, v113
    v_mul_f32 v114, s53, v114
    v_mul_f32 v115, s53, v115
    v_mul_f32 v116, s55, v116
    v_mul_f32 v117, s55, v117
    v_mul_f32 v118, s55, v118
    v_mul_f32 v119, s55, v119
    v_cvt_pk_bf16_f32 v18, v112, v116
    v_cvt_pk_bf16_f32 v19, v113, v117
    v_cvt_pk_bf16_f32 v20, v114, v118
    v_cvt_pk_bf16_f32 v21, v115, v119
    s_add_u32 s3, s95, 0xa000
    buffer_load_dwordx4 v[112:115], v2, s[96:99], s3 offen nt
    s_add_u32 s3, s95, 0xb000
    buffer_load_dwordx4 v[116:119], v2, s[96:99], s3 offen nt
    v_dot2c_f32_bf16 v36, s48, v18
    v_dot2c_f32_bf16 v37, s48, v19
    v_dot2c_f32_bf16 v38, s48, v20
    v_dot2c_f32_bf16 v39, s48, v21
    v_dot2c_f32_bf16 v40, s49, v18
    v_dot2c_f32_bf16 v41, s49, v19
    v_dot2c_f32_bf16 v42, s49, v20
    v_dot2c_f32_bf16 v43, s49, v21
    v_readlane_b32 s42, v55, 12
    v_readlane_b32 s43, v56, 12
    v_readlane_b32 s40, v52, 12
    v_readlane_b32 s41, v52, 44
    s_lshl_b32 s44, s42, 16
    s_and_b32 s45, s42, 0xffff0000
    s_lshl_b32 s46, s43, 16
    s_and_b32 s47, s43, 0xffff0000
    s_waitcnt vmcnt(14)
    v_cvt_f32_i32 v120, v120
    v_cvt_f32_i32 v121, v121
    v_cvt_f32_i32 v122, v122
    v_cvt_f32_i32 v123, v123
    v_cvt_f32_i32 v124, v124
    v_cvt_f32_i32 v125, v125
    v_cvt_f32_i32 v126, v126
    v_cvt_f32_i32 v127, v127
    v_subrev_f32 v120, s44, v120
    v_subrev_f32 v121, s44, v121
    v_subrev_f32 v122, s44, v122
    v_subrev_f32 v123, s44, v123
    v_subrev_f32 v124, s46, v124
    v_subrev_f32 v125, s46, v125
    v_subrev_f32 v126, s46, v126
    v_subrev_f32 v127, s46, v127
    v_cvt_pk_bf16_f32 v120, 0, v120
    v_cvt_pk_bf16_f32 v121, 0, v121
    v_cvt_pk_bf16_f32 v122, 0, v122
    v_cvt_pk_bf16_f32 v123, 0, v123
    v_cvt_pk_bf16_f32 v124, 0, v124
    v_cvt_pk_bf16_f32 v125, 0, v125
    v_cvt_pk_bf16_f32 v126, 0, v126
    v_cvt_pk_bf16_f32 v127, 0, v127
    v_mul_f32 v120, s45, v120
    v_mul_f32 v121, s45, v121
    v_mul_f32 v122, s45, v122
    v_mul_f32 v123, s45, v123
    v_mul_f32 v124, s47, v124
    v_mul_f32 v125, s47, v125
    v_mul_f32 v126, s47, v126
    v_mul_f32 v127, s47, v127
    v_cvt_pk_bf16_f32 v18, v120, v124
    v_cvt_pk_bf16_f32 v19, v121, v125
    v_cvt_pk_bf16_f32 v20, v122, v126
    v_cvt_pk_bf16_f32 v21, v123, v127
    s_add_u32 s3, s95, 0xc000
    buffer_load_dwordx4 v[120:123], v2, s[96:99], s3 offen nt
    s_add_u32 s3, s95, 0xd000
    buffer_load_dwordx4 v[124:127], v2, s[96:99], s3 offen nt
    v_dot2c_f32_bf16 v36, s40, v18
    v_dot2c_f32_bf16 v37, s40, v19
    v_dot2c_f32_bf16 v38, s40, v20
    v_dot2c_f32_bf16 v39, s40, v21
    v_dot2c_f32_bf16 v40, s41, v18
    v_dot2c_f32_bf16 v41, s41, v19
    v_dot2c_f32_bf16 v42, s41, v20
    v_dot2c_f32_bf16 v43, s41, v21
    v_readlane_b32 s50, v55, 28
    v_readlane_b32 s51, v56, 28
    v_readlane_b32 s48, v52, 28
    v_readlane_b32 s49, v52, 60
    s_lshl_b32 s52, s50, 16
    s_and_b32 s53, s50, 0xffff0000
    s_lshl_b32 s54, s51, 16
    s_and_b32 s55, s51, 0xffff0000
    s_waitcnt vmcnt(14)
    v_cvt_f32_i32 v128, v128
    v_cvt_f32_i32 v129, v129
    v_cvt_f32_i32 v130, v130
    v_cvt_f32_i32 v131, v131
    v_cvt_f32_i32 v132, v132
    v_cvt_f32_i32 v133, v133
    v_cvt_f32_i32 v134, v134
    v_cvt_f32_i32 v135, v135
    v_subrev_f32 v128, s52, v128
    v_subrev_f32 v129, s52, v129
    v_subrev_f32 v130, s52, v130
    v_subrev_f32 v131, s52, v131
    v_subrev_f32 v132, s54, v132
    v_subrev_f32 v133, s54, v133
    v_subrev_f32 v134, s54, v134
    v_subrev_f32 v135, s54, v135
    v_cvt_pk_bf16_f32 v128, 0, v128
    v_cvt_pk_bf16_f32 v129, 0, v129
    v_cvt_pk_bf16_f32 v130, 0, v130
    v_cvt_pk_bf16_f32 v131, 0, v131
    v_cvt_pk_bf16_f32 v132, 0, v132
    v_cvt_pk_bf16_f32 v133, 0, v133
    v_cvt_pk_bf16_f32 v134, 0, v134
    v_cvt_pk_bf16_f32 v135, 0, v135
    v_mul_f32 v128, s53, v128
    v_mul_f32 v129, s53, v129
    v_mul_f32 v130, s53, v130
    v_mul_f32 v131, s53, v131
    v_mul_f32 v132, s55, v132
    v_mul_f32 v133, s55, v133
    v_mul_f32 v134, s55, v134
    v_mul_f32 v135, s55, v135
    v_cvt_pk_bf16_f32 v18, v128, v132
    v_cvt_pk_bf16_f32 v19, v129, v133
    v_cvt_pk_bf16_f32 v20, v130, v134
    v_cvt_pk_bf16_f32 v21, v131, v135
    s_add_u32 s3, s95, 0xe000
    buffer_load_dwordx4 v[128:131], v2, s[96:99], s3 offen nt
    s_add_u32 s3, s95, 0xf000
    buffer_load_dwordx4 v[132:135], v2, s[96:99], s3 offen nt
    v_dot2c_f32_bf16 v36, s48, v18
    v_dot2c_f32_bf16 v37, s48, v19
    v_dot2c_f32_bf16 v38, s48, v20
    v_dot2c_f32_bf16 v39, s48, v21
    v_dot2c_f32_bf16 v40, s49, v18
    v_dot2c_f32_bf16 v41, s49, v19
    v_dot2c_f32_bf16 v42, s49, v20
    v_dot2c_f32_bf16 v43, s49, v21
    v_mov_b32_dpp v52, v52 quad_perm:[1,2,3,0] row_mask:0xf bank_mask:0xf
    v_mov_b32_dpp v55, v55 quad_perm:[1,2,3,0] row_mask:0xf bank_mask:0xf
    v_mov_b32_dpp v56, v56 quad_perm:[1,2,3,0] row_mask:0xf bank_mask:0xf
    s_cmp_lt_u32 s32, s34
    s_nop 3
    s_cbranch_scc1 L_vloop
    s_cmp_lg_u32 s93, 0
    s_cbranch_scc1 L_task
    s_lshl_b32 s47, s28, 8
    s_add_u32 s47, s47, 12582912
    v_mov_b32 v50, s47
    s_cmp_lg_u32 s33, 0
    s_cbranch_scc1 L_notick
    v_mov_b32 v45, 0x1000000
    s_mov_b64 exec, 1
    global_atomic_add v51, v50, v45, s[22:23] sc0 sc1
    s_mov_b64 exec, -1
    s_nop 1
L_notick:
    s_lshl_b32 s36, s33, 11
    v_add_u32 v44, s36, v3
    ds_write_b128 v44, v[36:39]
    ds_write_b128 v44, v[40:43] offset:1024
    v_lshrrev_b32 v45, 5, v1
    v_lshlrev_b32 v45, 7, v45
    s_lshl_b32 s36, s33, 2
    s_add_u32 s36, s36, 8192
    v_add_u32 v45, s36, v45
    ds_write_b32 v45, v53
    ds_write_b32 v45, v54 offset:256
    v_mov_b32 v47, 8720
    s_waitcnt vmcnt(0)
    s_cmp_lg_u32 s33, 0
    s_cbranch_scc1 L_notick2
    s_mov_b64 exec, 1
    ds_write_b32 v47, v51
    s_mov_b64 exec, -1
L_notick2:
    s_waitcnt lgkmcnt(0)
    s_barrier
    v_lshlrev_b32 v46, 2, v0
    v_mov_b32 v45, 8192
    ds_read_b32 v51, v47
    ds_read_b128 v[60:63], v45 offset:0
    ds_read_b128 v[64:67], v45 offset:256
    ds_read_b32 v68, v46 offset:0
    ds_read_b32 v69, v46 offset:2048
    ds_read_b32 v70, v46 offset:4096
    ds_read_b32 v71, v46 offset:6144
    ds_read_b128 v[72:75], v45 offset:128
    ds_read_b128 v[76:79], v45 offset:384
    ds_read_b32 v80, v46 offset:1024
    ds_read_b32 v81, v46 offset:3072
    ds_read_b32 v82, v46 offset:5120
    ds_read_b32 v83, v46 offset:7168
    s_waitcnt lgkmcnt(0)
    v_readfirstlane_b32 s40, v51
    s_nop 1
    s_bfe_u32 s41, s40, 0x40018
    s_lshr_b32 s42, s40, 28
    s_cmp_lg_u32 s41, 3
    s_cbranch_scc1 L_wgc
    s_mov_b32 s43, 0
L_spoll:
    s_cmp_ge_u32 s42, 3
    s_cbranch_scc1 L_sok
    s_add_u32 s43, s43, 1
    s_cmp_gt_u32 s43, 0x20000
    s_cbranch_scc1 L_sok
    global_load_dword v51, v50, s[22:23] sc1
    s_waitcnt vmcnt(0)
    v_readfirstlane_b32 s42, v51
    s_nop 1
    s_lshr_b32 s42, s42, 28
    s_branch L_spoll
L_sok:
    s_add_u32 s36, s2, 1
    s_and_b32 s36, s36, 3
    s_lshl_b32 s37, s28, 2
    s_add_u32 s36, s36, s37
    s_lshl_b32 s37, s36, 4
    s_add_u32 s37, s37, 8388608
    v_mov_b32 v48, s37
    s_lshl_b32 s37, s36, 11
    v_add_u32 v47, s37, v46
    global_load_dwordx4 v[92:95], v48, s[22:23] sc1
    global_load_dword v104, v47, s[22:23] sc1
    global_load_dword v105, v47, s[22:23] offset:1024 sc1
    s_add_u32 s36, s2, 2
    s_and_b32 s36, s36, 3
    s_lshl_b32 s37, s28, 2
    s_add_u32 s36, s36, s37
    s_lshl_b32 s37, s36, 4
    s_add_u32 s37, s37, 8388608
    v_mov_b32 v48, s37
    s_lshl_b32 s37, s36, 11
    v_add_u32 v47, s37, v46
    global_load_dwordx4 v[96:99], v48, s[22:23] sc1
    global_load_dword v106, v47, s[22:23] sc1
    global_load_dword v107, v47, s[22:23] offset:1024 sc1
    s_add_u32 s36, s2, 3
    s_and_b32 s36, s36, 3
    s_lshl_b32 s37, s28, 2
    s_add_u32 s36, s36, s37
    s_lshl_b32 s37, s36, 4
    s_add_u32 s37, s37, 8388608
    v_mov_b32 v48, s37
    s_lshl_b32 s37, s36, 11
    v_add_u32 v47, s37, v46
    global_load_dwordx4 v[100:103], v48, s[22:23] sc1
    global_load_dword v108, v47, s[22:23] sc1
    global_load_dword v109, v47, s[22:23] offset:1024 sc1
    s_nop 1
L_wgc:
    v_max3_f32 v84, v60, v61, v62
    v_max_f32 v84, v84, v63
    v_sub_f32 v60, v60, v84
    v_mul_f32 v60, s92, v60
    v_exp_f32 v60, v60
    v_sub_f32 v61, v61, v84
    v_mul_f32 v61, s92, v61
    v_exp_f32 v61, v61
    v_sub_f32 v62, v62, v84
    v_mul_f32 v62, s92, v62
    v_exp_f32 v62, v62
    v_sub_f32 v63, v63, v84
    v_mul_f32 v63, s92, v63
    v_exp_f32 v63, v63
    v_mul_f32 v85, v60, v64
    v_mul_f32 v86, v60, v68
    v_fmac_f32 v85, v61, v65
    v_fmac_f32 v86, v61, v69
    v_fmac_f32 v85, v62, v66
    v_fmac_f32 v86, v62, v70
    v_fmac_f32 v85, v63, v67
    v_fmac_f32 v86, v63, v71
    v_max3_f32 v88, v72, v73, v74
    v_max_f32 v88, v88, v75
    v_sub_f32 v72, v72, v88
    v_mul_f32 v72, s92, v72
    v_exp_f32 v72, v72
    v_sub_f32 v73, v73, v88
    v_mul_f32 v73, s92, v73
    v_exp_f32 v73, v73
    v_sub_f32 v74, v74, v88
    v_mul_f32 v74, s92, v74
    v_exp_f32 v74, v74
    v_sub_f32 v75, v75, v88
    v_mul_f32 v75, s92, v75
    v_exp_f32 v75, v75
    v_mul_f32 v89, v72, v76
    v_mul_f32 v90, v72, v80
    v_fmac_f32 v89, v73, v77
    v_fmac_f32 v90, v73, v81
    v_fmac_f32 v89, v74, v78
    v_fmac_f32 v90, v74, v82
    v_fmac_f32 v89, v75, v79
    v_fmac_f32 v90, v75, v83
    s_cmp_eq_u32 s41, 3
    s_cbranch_scc1 L_final
    s_lshl_b32 s36, s2, 11
    v_add_u32 v47, s36, v46
    global_store_dword v47, v86, s[22:23] sc1
    global_store_dword v47, v90, s[22:23] offset:1024 sc1
    s_cmp_lg_u32 s33, 0
    s_cbranch_scc1 L_nostat
    s_lshl_b32 s36, s2, 4
    s_add_u32 s36, s36, 8388608
    v_mov_b32 v48, s36
    s_mov_b64 exec, 1
    global_store_dwordx2 v48, v[84:85], s[22:23] sc1
    global_store_dwordx2 v48, v[88:89], s[22:23] offset:8 sc1
    s_mov_b64 exec, -1
    s_nop 0
L_nostat:
    s_waitcnt vmcnt(0)
    s_barrier
    s_cmp_lg_u32 s33, 0
    s_cbranch_scc1 L_end
    v_mov_b32 v45, 0x10000000
    s_mov_b64 exec, 1
    global_atomic_add v50, v45, s[22:23] sc1
    s_branch L_end
    s_nop 1
L_final:
    s_waitcnt vmcnt(0)
    s_lshl_b32 s39, s28, 10
    v_lshlrev_b32 v46, 1, v0
    v_add_u32 v46, s39, v46
    v_max3_f32 v44, v84, v92, v96
    v_max_f32 v44, v44, v100
    v_sub_f32 v84, v84, v44
    v_mul_f32 v84, s92, v84
    v_exp_f32 v84, v84
    v_sub_f32 v92, v92, v44
    v_mul_f32 v92, s92, v92
    v_exp_f32 v92, v92
    v_sub_f32 v96, v96, v44
    v_mul_f32 v96, s92, v96
    v_exp_f32 v96, v96
    v_sub_f32 v100, v100, v44
    v_mul_f32 v100, s92, v100
    v_exp_f32 v100, v100
    v_mul_f32 v45, v84, v85
    v_mul_f32 v48, v84, v86
    v_fmac_f32 v45, v92, v93
    v_fmac_f32 v48, v92, v104
    v_fmac_f32 v45, v96, v97
    v_fmac_f32 v48, v96, v106
    v_fmac_f32 v45, v100, v101
    v_fmac_f32 v48, v100, v108
    v_rcp_f32 v45, v45
    s_nop 0
    v_mul_f32 v48, v48, v45
    v_cvt_pk_bf16_f32 v48, v48, v48
    global_store_short v46, v48, s[18:19] offset:0
    v_max3_f32 v44, v88, v94, v98
    v_max_f32 v44, v44, v102
    v_sub_f32 v88, v88, v44
    v_mul_f32 v88, s92, v88
    v_exp_f32 v88, v88
    v_sub_f32 v94, v94, v44
    v_mul_f32 v94, s92, v94
    v_exp_f32 v94, v94
    v_sub_f32 v98, v98, v44
    v_mul_f32 v98, s92, v98
    v_exp_f32 v98, v98
    v_sub_f32 v102, v102, v44
    v_mul_f32 v102, s92, v102
    v_exp_f32 v102, v102
    v_mul_f32 v45, v88, v89
    v_mul_f32 v48, v88, v90
    v_fmac_f32 v45, v94, v95
    v_fmac_f32 v48, v94, v105
    v_fmac_f32 v45, v98, v99
    v_fmac_f32 v48, v98, v107
    v_fmac_f32 v45, v102, v103
    v_fmac_f32 v48, v102, v109
    v_rcp_f32 v45, v45
    s_nop 0
    v_mul_f32 v48, v48, v45
    v_cvt_pk_bf16_f32 v48, v48, v48
    global_store_short v46, v48, s[18:19] offset:512
    s_branch L_end
    s_nop 2
L_helper:
    s_mov_b64 exec, 1
    s_and_b32 s40, s2, 3
    s_lshl_b32 s47, s28, 8
    s_add_u32 s47, s47, 12582912
    v_mov_b32 v48, s47
    s_mov_b32 s38, s40
    s_barrier
    s_add_u32 s38, s38, 4
    s_lshl_b32 s39, s29, 2
    s_add_u32 s39, s39, 8704
    v_mov_b32 v68, s39
    v_mov_b32 v69, s38
    s_xor_b32 s29, s29, 1
    ds_write_b32 v68, v69
    s_waitcnt lgkmcnt(0)
    s_barrier
    s_cmp_lg_u32 s40, 0
    s_cbranch_scc1 L_hnoinit
    v_mov_b32 v47, 2
    global_atomic_or v46, v49, v47, s[20:21] sc0 sc1
    s_waitcnt vmcnt(0)
    v_readfirstlane_b32 s41, v46
    s_nop 1
    s_and_b32 s41, s41, 2
    s_cmp_lg_u32 s41, 0
    s_cbranch_scc1 L_lostA
    v_mov_b32 v47, 0
    global_store_dword v48, v47, s[22:23] sc1
    s_waitcnt vmcnt(0)
    v_mov_b32 v47, 1
    global_atomic_or v49, v47, s[20:21] sc1
    s_nop 3
L_lostA:
L_hnoinit:
L_hstatic:
    s_barrier
    s_add_u32 s38, s38, 4
    s_lshl_b32 s39, s29, 2
    s_add_u32 s39, s39, 8704
    v_mov_b32 v68, s39
    v_mov_b32 v69, s38
    s_xor_b32 s29, s29, 1
    ds_write_b32 v68, v69
    s_waitcnt lgkmcnt(0)
    s_barrier
    s_cmp_lt_u32 s38, 8
    s_cbranch_scc1 L_hstatic
    global_load_dword v47, v49, s[20:21] sc1
    s_waitcnt vmcnt(0)
    v_readfirstlane_b32 s41, v47
    s_nop 1
    s_and_b32 s41, s41, 1
    s_cmp_eq_u32 s41, 1
    s_cbranch_scc1 L_hnext
    v_mov_b32 v47, 2
    global_atomic_or v46, v49, v47, s[20:21] sc0 sc1
    s_waitcnt vmcnt(0)
    v_readfirstlane_b32 s41, v46
    s_nop 1
    s_and_b32 s41, s41, 2
    s_cmp_lg_u32 s41, 0
    s_cbranch_scc1 L_lostB
    v_mov_b32 v47, 0
    global_store_dword v48, v47, s[22:23] sc1
    s_waitcnt vmcnt(0)
    v_mov_b32 v47, 1
    global_atomic_or v49, v47, s[20:21] sc1
    s_nop 3
L_lostB:
    s_mov_b32 s43, 0
L_hpoll:
    global_load_dword v47, v49, s[20:21] sc1
    s_waitcnt vmcnt(0)
    v_readfirstlane_b32 s41, v47
    s_nop 1
    s_and_b32 s41, s41, 1
    s_cmp_eq_u32 s41, 1
    s_cbranch_scc1 L_hnext
    s_add_u32 s43, s43, 1
    s_cmp_gt_u32 s43, 0x20000
    s_cbranch_scc1 L_hnext
    s_sleep 8
    s_branch L_hpoll
L_hnext:
    s_barrier
L_hloop:
    s_mul_i32 s42, s40, 6
    s_lshl_b32 s43, 1, s42
    v_mov_b32 v50, s43
    global_atomic_add v51, v48, v50, s[22:23] sc0 sc1
    s_waitcnt vmcnt(0)
    v_readfirstlane_b32 s41, v51
    s_nop 1
    s_lshr_b32 s44, s41, s42
    s_and_b32 s44, s44, 63
    s_cmp_lt_u32 s44, 6
    s_cbranch_scc1 L_hgot
    s_mov_b32 s45, 63
    s_bfe_u32 s46, s41, 0x60000
    s_cmp_lt_u32 s46, s45
    s_cselect_b32 s45, s46, s45
    s_cselect_b32 s40, 0, s40
    s_bfe_u32 s46, s41, 0x60006
    s_cmp_lt_u32 s46, s45
    s_cselect_b32 s45, s46, s45
    s_cselect_b32 s40, 1, s40
    s_bfe_u32 s46, s41, 0x6000c
    s_cmp_lt_u32 s46, s45
    s_cselect_b32 s45, s46, s45
    s_cselect_b32 s40, 2, s40
    s_bfe_u32 s46, s41, 0x60012
    s_cmp_lt_u32 s46, s45
    s_cselect_b32 s45, s46, s45
    s_cselect_b32 s40, 3, s40
    s_cmp_lt_u32 s45, 6
    s_cbranch_scc1 L_hloop
    s_mov_b32 s38, 36
    s_branch L_hpub
L_hgot:
    s_add_u32 s38, s44, 3
    s_lshl_b32 s38, s38, 2
    s_add_u32 s38, s38, s40
L_hpub:
    s_lshl_b32 s39, s29, 2
    s_add_u32 s39, s39, 8704
    v_mov_b32 v68, s39
    v_mov_b32 v69, s38
    s_xor_b32 s29, s29, 1
    ds_write_b32 v68, v69
    s_waitcnt lgkmcnt(0)
    s_barrier
    s_cmp_lt_u32 s38, 36
    s_cbranch_scc1 L_hnext
L_end:
    s_endpgm

.section .rodata,"a"
.p2align 6
.amdhsa_kernel standalone__kv_cache_quant_int4_int2_kv_with_per_channel_or_per_token_scales__decode_kernel
  .amdhsa_next_free_vgpr 136
  .amdhsa_next_free_sgpr 102
  .amdhsa_accum_offset 136
  .amdhsa_group_segment_fixed_size 0
  .amdhsa_kernarg_size 80
  .amdhsa_user_sgpr_count 2
  .amdhsa_user_sgpr_kernarg_segment_ptr 1
  .amdhsa_system_sgpr_workgroup_id_x 1
  .amdhsa_float_denorm_mode_32 3
.end_amdhsa_kernel
```
